```python
import torch

def _softmax(x, axis=-1):
    return torch.softmax(x, dim=axis)
def _gelu(x):
    return torch.nn.functional.gelu(x, approximate="tanh")
def _silu(x):
    return torch.nn.functional.silu(x)
def _sigmoid(x):
    return torch.sigmoid(x)
def _layernorm(x, axis=-1, eps=1e-5):
    m = x.mean(dim=axis, keepdim=True)
    v = x.var(dim=axis, keepdim=True, unbiased=False)
    return (x - m) / torch.sqrt(v + eps)
def _scatter_add(tgt, idx, src, axis=0):
    return tgt.clone().index_add_(axis, idx, src)
def _segment_sum(src, seg, n):
    out = torch.zeros((n,) + src.shape[1:], dtype=src.dtype)
    return out.index_add_(0, seg, src)
def _pad(x, pw):
    flat = tuple(v for pair in reversed(pw) for v in pair)
    return torch.nn.functional.pad(x, flat)

kernel_name = 'standalone__gqa_softmax__sampling'

def setup_inputs():

    _w = (lambda a: (lambda t: t.to(torch.bfloat16) if t.is_floating_point() else t)(torch.as_tensor(a)))
    B, Hq, Hkv, Sq, Sk, D = 32, 32, 8, 8, 2048, 128
    return {
        "q": _w((lambda *s: torch.randn(*s, dtype=torch.bfloat16) * 0.8)(B, Hq, Sq, D)),
        "k": _w((lambda *s: torch.randn(*s, dtype=torch.bfloat16) * 0.8)(B, Hkv, Sk, D)),
        "v": _w((lambda *s: torch.randn(*s, dtype=torch.bfloat16) * 0.05)(B, Hkv, Sk, D)),
    }

def reference(q, k, v):
    B, Hq, Sq, D = q.shape
    Hkv = k.shape[1]
    rep = Hq // Hkv
    k = (lambda x, n, axis: torch.repeat_interleave(x, n, dim=axis))(k, rep, axis=1)
    v = (lambda x, n, axis: torch.repeat_interleave(x, n, dim=axis))(v, rep, axis=1)
    scale = D ** -0.5
    scores = torch.einsum("bhqd,bhkd->bhqk", q, k) * scale
    p = _softmax(scores, axis=-1)
    return torch.einsum("bhqk,bhkd->bhqd", p, v)
```

```asm
; @launch grid=(256,1,1) block=(256,1,1) lds=126976
.amdgcn_target "amdgcn-amd-amdhsa--gfx950"
.text
.globl standalone__gqa_softmax__sampling_kernel
.p2align 8
.type standalone__gqa_softmax__sampling_kernel,@function
standalone__gqa_softmax__sampling_kernel:
    s_load_dwordx8 s[4:11], s[0:1], 0
    s_cmp_ge_u32 s2, 256
    s_cbranch_scc1 L_end
    s_and_b32 s33, s2, 7
    s_lshr_b32 s35, s2, 3
    s_lshl_b32 s33, s33, 5
    s_or_b32 s33, s33, s35
    s_lshl_b32 s35, s33, 19
    s_lshl_b32 s33, s33, 13
    v_lshrrev_b32 v14, 6, v0
    v_and_b32 v7, 63, v0
    v_lshlrev_b32 v15, 13, v14
    v_and_b32 v16, 3, v0
    v_bfe_u32 v17, v0, 2, 2
    v_lshl_add_u32 v16, v16, 2, v17
    v_lshl_add_u32 v16, v16, 8, v15
    v_and_b32 v17, 0x30, v0
    v_add_u32 v1, v16, v17
    v_add_u32 v2, 4096, v1
    v_and_b32 v16, 15, v0
    v_lshl_add_u32 v16, v16, 8, v17
    v_bfe_u32 v18, v0, 7, 1
    v_lshl_add_u32 v5, v18, 12, v16
    v_lshrrev_b32 v19, 4, v7
    v_lshl_add_u32 v19, v14, 3, v19
    v_xor_b32 v20, v19, v0
    v_and_b32 v20, 15, v20
    v_lshlrev_b32 v20, 4, v20
    v_lshl_add_u32 v6, v19, 8, v20
    v_xor_b32 v21, 64, v6
    v_readfirstlane_b32 s36, v14
    s_nop 0
    s_lshl_b32 s36, s36, 11
    s_add_u32 m0, s36, 53248
    v_bfe_u32 v18, v0, 6, 1
    v_lshlrev_b32 v19, 1, v18
    v_xor_b32 v19, v19, v7
    v_lshl_add_u32 v3, v19, 4, v15
    v_add_u32 v4, 4096, v3
    s_mov_b32 s14, 524288
    s_mov_b32 s15, 0x20000
    s_mov_b32 s18, 524288
    s_mov_b32 s19, 0x20000
    s_mov_b32 s22, 8192
    s_mov_b32 s23, 0x20000
    s_mov_b32 s26, 8192
    s_mov_b32 s27, 0x20000
    s_mov_b32 s31, 0
    s_mov_b32 s32, 0
    s_waitcnt lgkmcnt(0)
    s_add_u32 s20, s4, s33
    s_addc_u32 s21, s5, 0
    buffer_load_dwordx4 v6, s[20:23], 0 offen nt lds
    buffer_load_dwordx4 v21, s[20:23], 0 offen offset:1024 nt lds
    s_add_u32 s12, s6, s35
    s_addc_u32 s13, s7, 0
    s_add_u32 s16, s8, s35
    s_addc_u32 s17, s9, 0
    buffer_load_dwordx4 a[32:35], v1, s[12:15], s31 offen offset:0 nt
    buffer_load_dwordx4 a[36:39], v1, s[12:15], s31 offen offset:64 nt
    buffer_load_dwordx4 a[40:43], v1, s[12:15], s31 offen offset:128 nt
    buffer_load_dwordx4 a[44:47], v1, s[12:15], s31 offen offset:192 nt
    buffer_load_dwordx4 v[148:151], v3, s[16:19], s32 offen offset:0 nt
    buffer_load_dwordx4 v[152:155], v3, s[16:19], s32 offen offset:1024 nt
    buffer_load_dwordx4 v[156:159], v3, s[16:19], s32 offen offset:2048 nt
    buffer_load_dwordx4 v[160:163], v3, s[16:19], s32 offen offset:3072 nt
    s_add_u32 s24, s10, s33
    s_addc_u32 s25, s11, 0
    s_mov_b32 s28, 0x3e0293ee
    s_mov_b32 s29, 0x05040100
    s_mov_b32 s30, 0x07060302
    v_lshlrev_b32 v15, 12, v14
    v_lshl_add_u32 v26, v7, 3, v15
    v_and_b32 v16, 0x1f00, v5
    v_lshlrev_b32 v17, 2, v17
    v_lshl_add_u32 v17, v18, 5, v17
    v_add_u32 v27, v16, v17
    v_mov_b32 v8, 0xff61b1e6
    v_mov_b32 v10, 0
    v_mov_b32 v9, 0xff61b1e6
    v_mov_b32 v11, 0
    v_pk_mul_f32 v[84:85], v[10:11], 0 op_sel_hi:[1,0]
    v_pk_mul_f32 v[86:87], v[10:11], 0 op_sel_hi:[1,0]
    v_pk_mul_f32 v[88:89], v[10:11], 0 op_sel_hi:[1,0]
    v_pk_mul_f32 v[90:91], v[10:11], 0 op_sel_hi:[1,0]
    v_pk_mul_f32 v[92:93], v[10:11], 0 op_sel_hi:[1,0]
    v_pk_mul_f32 v[94:95], v[10:11], 0 op_sel_hi:[1,0]
    v_pk_mul_f32 v[96:97], v[10:11], 0 op_sel_hi:[1,0]
    v_pk_mul_f32 v[98:99], v[10:11], 0 op_sel_hi:[1,0]
    v_pk_mul_f32 v[100:101], v[10:11], 0 op_sel_hi:[1,0]
    v_pk_mul_f32 v[102:103], v[10:11], 0 op_sel_hi:[1,0]
    v_pk_mul_f32 v[104:105], v[10:11], 0 op_sel_hi:[1,0]
    v_pk_mul_f32 v[106:107], v[10:11], 0 op_sel_hi:[1,0]
    v_pk_mul_f32 v[108:109], v[10:11], 0 op_sel_hi:[1,0]
    v_pk_mul_f32 v[110:111], v[10:11], 0 op_sel_hi:[1,0]
    v_pk_mul_f32 v[112:113], v[10:11], 0 op_sel_hi:[1,0]
    v_pk_mul_f32 v[114:115], v[10:11], 0 op_sel_hi:[1,0]
    v_pk_mul_f32 v[116:117], v[10:11], 0 op_sel_hi:[1,0]
    v_pk_mul_f32 v[118:119], v[10:11], 0 op_sel_hi:[1,0]
    v_pk_mul_f32 v[120:121], v[10:11], 0 op_sel_hi:[1,0]
    v_pk_mul_f32 v[122:123], v[10:11], 0 op_sel_hi:[1,0]
    v_pk_mul_f32 v[124:125], v[10:11], 0 op_sel_hi:[1,0]
    v_pk_mul_f32 v[126:127], v[10:11], 0 op_sel_hi:[1,0]
    v_pk_mul_f32 v[128:129], v[10:11], 0 op_sel_hi:[1,0]
    v_pk_mul_f32 v[130:131], v[10:11], 0 op_sel_hi:[1,0]
    v_pk_mul_f32 v[132:133], v[10:11], 0 op_sel_hi:[1,0]
    v_pk_mul_f32 v[134:135], v[10:11], 0 op_sel_hi:[1,0]
    v_pk_mul_f32 v[136:137], v[10:11], 0 op_sel_hi:[1,0]
    v_pk_mul_f32 v[138:139], v[10:11], 0 op_sel_hi:[1,0]
    v_pk_mul_f32 v[140:141], v[10:11], 0 op_sel_hi:[1,0]
    v_pk_mul_f32 v[142:143], v[10:11], 0 op_sel_hi:[1,0]
    v_pk_mul_f32 v[144:145], v[10:11], 0 op_sel_hi:[1,0]
    v_pk_mul_f32 v[146:147], v[10:11], 0 op_sel_hi:[1,0]
    s_waitcnt vmcnt(8)
    s_barrier
    v_and_b32 v16, 15, v0
    v_bfe_u32 v17, v0, 4, 2
    v_xor_b32 v17, v17, v16
    v_lshlrev_b32 v17, 4, v17
    v_and_b32 v16, 0x1f00, v5
    v_add_u32 v28, v16, v17
    v_xor_b32 v29, 64, v28
    v_xor_b32 v30, 128, v28
    v_xor_b32 v31, 192, v28
    v_xor_b32 v32, 4096, v28
    v_xor_b32 v33, 4160, v28
    v_xor_b32 v34, 4224, v28
    v_xor_b32 v35, 4288, v28
    ds_read_b128 a[0:3], v28 offset:53248
    ds_read_b128 a[4:7], v29 offset:53248
    ds_read_b128 a[8:11], v30 offset:53248
    ds_read_b128 a[12:15], v31 offset:53248
    ds_read_b128 a[16:19], v32 offset:53248
    ds_read_b128 a[20:23], v33 offset:53248
    ds_read_b128 a[24:27], v34 offset:53248
    ds_read_b128 a[28:31], v35 offset:53248
    s_waitcnt lgkmcnt(0)
L_loop:
    s_waitcnt vmcnt(5)
    buffer_load_dwordx4 a[48:51], v2, s[12:15], s31 offen offset:0 nt
    buffer_load_dwordx4 a[52:55], v2, s[12:15], s31 offen offset:64 nt
    buffer_load_dwordx4 a[56:59], v2, s[12:15], s31 offen offset:128 nt
    buffer_load_dwordx4 a[60:63], v2, s[12:15], s31 offen offset:192 nt
    buffer_load_dwordx4 v[164:167], v4, s[16:19], s32 offen offset:0 nt
    buffer_load_dwordx4 v[168:171], v4, s[16:19], s32 offen offset:1024 nt
    buffer_load_dwordx4 v[172:175], v4, s[16:19], s32 offen offset:2048 nt
    buffer_load_dwordx4 v[176:179], v4, s[16:19], s32 offen offset:3072 nt
    s_add_u32 s31, s31, 32768
    s_add_u32 s32, s32, 32768
    s_waitcnt vmcnt(12)
    v_mfma_f32_16x16x32_bf16 v[28:31], a[32:35], a[0:3], 0
    v_mfma_f32_16x16x32_bf16 v[32:35], a[32:35], a[16:19], 0
    v_mfma_f32_16x16x32_bf16 v[28:31], a[36:39], a[4:7], v[28:31]
    v_mfma_f32_16x16x32_bf16 v[32:35], a[36:39], a[20:23], v[32:35]
    v_mfma_f32_16x16x32_bf16 v[28:31], a[40:43], a[8:11], v[28:31]
    v_mfma_f32_16x16x32_bf16 v[32:35], a[40:43], a[24:27], v[32:35]
    v_mfma_f32_16x16x32_bf16 v[28:31], a[44:47], a[12:15], v[28:31]
    v_mfma_f32_16x16x32_bf16 v[32:35], a[44:47], a[28:31], v[32:35]
    s_waitcnt vmcnt(8)
    v_perm_b32 v52, v152, v148, s29
    v_perm_b32 v53, v160, v156, s29
    v_perm_b32 v56, v152, v148, s30
    v_perm_b32 v57, v160, v156, s30
    v_perm_b32 v60, v153, v149, s29
    v_perm_b32 v61, v161, v157, s29
    v_perm_b32 v64, v153, v149, s30
    v_perm_b32 v65, v161, v157, s30
    v_perm_b32 v68, v154, v150, s29
    v_perm_b32 v69, v162, v158, s29
    v_perm_b32 v72, v154, v150, s30
    v_perm_b32 v73, v162, v158, s30
    v_perm_b32 v76, v155, v151, s29
    v_perm_b32 v77, v163, v159, s29
    v_perm_b32 v80, v155, v151, s30
    v_perm_b32 v81, v163, v159, s30
    s_waitcnt vmcnt(5)
    buffer_load_dwordx4 a[32:35], v1, s[12:15], s31 offen offset:0 nt
    buffer_load_dwordx4 a[36:39], v1, s[12:15], s31 offen offset:64 nt
    buffer_load_dwordx4 a[40:43], v1, s[12:15], s31 offen offset:128 nt
    buffer_load_dwordx4 a[44:47], v1, s[12:15], s31 offen offset:192 nt
    buffer_load_dwordx4 v[148:151], v3, s[16:19], s32 offen offset:0 nt
    buffer_load_dwordx4 v[152:155], v3, s[16:19], s32 offen offset:1024 nt
    buffer_load_dwordx4 v[156:159], v3, s[16:19], s32 offen offset:2048 nt
    buffer_load_dwordx4 v[160:163], v3, s[16:19], s32 offen offset:3072 nt
    s_waitcnt vmcnt(12)
    v_mfma_f32_16x16x32_bf16 v[36:39], a[48:51], a[0:3], 0
    v_mfma_f32_16x16x32_bf16 v[40:43], a[48:51], a[16:19], 0
    v_mfma_f32_16x16x32_bf16 v[36:39], a[52:55], a[4:7], v[36:39]
    v_mfma_f32_16x16x32_bf16 v[40:43], a[52:55], a[20:23], v[40:43]
    v_mfma_f32_16x16x32_bf16 v[36:39], a[56:59], a[8:11], v[36:39]
    v_mfma_f32_16x16x32_bf16 v[40:43], a[56:59], a[24:27], v[40:43]
    v_mfma_f32_16x16x32_bf16 v[36:39], a[60:63], a[12:15], v[36:39]
    v_mfma_f32_16x16x32_bf16 v[40:43], a[60:63], a[28:31], v[40:43]
    s_waitcnt vmcnt(8)
    v_perm_b32 v54, v168, v164, s29
    v_perm_b32 v55, v176, v172, s29
    v_perm_b32 v58, v168, v164, s30
    v_perm_b32 v59, v176, v172, s30
    v_perm_b32 v62, v169, v165, s29
    v_perm_b32 v63, v177, v173, s29
    v_perm_b32 v66, v169, v165, s30
    v_perm_b32 v67, v177, v173, s30
    v_perm_b32 v70, v170, v166, s29
    v_perm_b32 v71, v178, v174, s29
    v_perm_b32 v74, v170, v166, s30
    v_perm_b32 v75, v178, v174, s30
    v_perm_b32 v78, v171, v167, s29
    v_perm_b32 v79, v179, v175, s29
    v_perm_b32 v82, v171, v167, s30
    v_perm_b32 v83, v179, v175, s30
    v_max3_f32 v12, v28, v29, v30
    v_max3_f32 v14, v31, v36, v37
    v_max3_f32 v12, v38, v39, v12
    v_max3_f32 v12, v12, v14, v8
    v_max3_f32 v13, v32, v33, v34
    v_max3_f32 v15, v35, v40, v41
    v_max3_f32 v13, v42, v43, v13
    v_max3_f32 v13, v13, v15, v9
    s_nop 1
    v_permlane32_swap_b32 v12, v13
    v_max_f32 v12, v12, v13
    v_mov_b32 v13, v12
    s_nop 1
    v_permlane16_swap_b32 v12, v13
    v_max_f32 v12, v12, v13
    v_mov_b32 v13, v12
    s_nop 1
    v_permlane32_swap_b32 v12, v13
    v_mul_f32 v20, s28, v12
    v_mul_f32 v21, s28, v13
    v_fma_f32 v22, v8, s28, -v20
    v_fma_f32 v24, v9, s28, -v21
    v_mov_b32 v8, v12
    v_mov_b32 v9, v13
    v_exp_f32 v22, v22
    v_exp_f32 v24, v24
    v_fma_f32 v28, v28, s28, -v20
    v_fma_f32 v29, v29, s28, -v20
    v_fma_f32 v30, v30, s28, -v20
    v_fma_f32 v31, v31, s28, -v20
    v_fma_f32 v36, v36, s28, -v20
    v_fma_f32 v37, v37, s28, -v20
    v_fma_f32 v38, v38, s28, -v20
    v_fma_f32 v39, v39, s28, -v20
    v_fma_f32 v32, v32, s28, -v21
    v_fma_f32 v33, v33, s28, -v21
    v_fma_f32 v34, v34, s28, -v21
    v_fma_f32 v35, v35, s28, -v21
    v_fma_f32 v40, v40, s28, -v21
    v_fma_f32 v41, v41, s28, -v21
    v_fma_f32 v42, v42, s28, -v21
    v_fma_f32 v43, v43, s28, -v21
    v_exp_f32 v28, v28
    v_exp_f32 v29, v29
    v_exp_f32 v30, v30
    v_exp_f32 v31, v31
    v_exp_f32 v36, v36
    v_exp_f32 v37, v37
    v_exp_f32 v38, v38
    v_exp_f32 v39, v39
    v_exp_f32 v32, v32
    v_exp_f32 v33, v33
    v_exp_f32 v34, v34
    v_exp_f32 v35, v35
    v_exp_f32 v40, v40
    v_exp_f32 v41, v41
    v_exp_f32 v42, v42
    v_exp_f32 v43, v43
    v_pk_mul_f32 v[84:85], v[84:85], v[22:23] op_sel_hi:[1,0]
    v_pk_mul_f32 v[86:87], v[86:87], v[22:23] op_sel_hi:[1,0]
    v_pk_mul_f32 v[88:89], v[88:89], v[22:23] op_sel_hi:[1,0]
    v_pk_mul_f32 v[90:91], v[90:91], v[22:23] op_sel_hi:[1,0]
    v_pk_mul_f32 v[92:93], v[92:93], v[22:23] op_sel_hi:[1,0]
    v_pk_mul_f32 v[94:95], v[94:95], v[22:23] op_sel_hi:[1,0]
    v_pk_mul_f32 v[96:97], v[96:97], v[22:23] op_sel_hi:[1,0]
    v_pk_mul_f32 v[98:99], v[98:99], v[22:23] op_sel_hi:[1,0]
    v_pk_mul_f32 v[100:101], v[100:101], v[22:23] op_sel_hi:[1,0]
    v_pk_mul_f32 v[102:103], v[102:103], v[22:23] op_sel_hi:[1,0]
    v_pk_mul_f32 v[104:105], v[104:105], v[22:23] op_sel_hi:[1,0]
    v_pk_mul_f32 v[106:107], v[106:107], v[22:23] op_sel_hi:[1,0]
    v_pk_mul_f32 v[108:109], v[108:109], v[22:23] op_sel_hi:[1,0]
    v_pk_mul_f32 v[110:111], v[110:111], v[22:23] op_sel_hi:[1,0]
    v_pk_mul_f32 v[112:113], v[112:113], v[22:23] op_sel_hi:[1,0]
    v_pk_mul_f32 v[114:115], v[114:115], v[22:23] op_sel_hi:[1,0]
    v_pk_mul_f32 v[116:117], v[116:117], v[24:25] op_sel_hi:[1,0]
    v_pk_mul_f32 v[118:119], v[118:119], v[24:25] op_sel_hi:[1,0]
    v_pk_mul_f32 v[120:121], v[120:121], v[24:25] op_sel_hi:[1,0]
    v_pk_mul_f32 v[122:123], v[122:123], v[24:25] op_sel_hi:[1,0]
    v_pk_mul_f32 v[124:125], v[124:125], v[24:25] op_sel_hi:[1,0]
    v_pk_mul_f32 v[126:127], v[126:127], v[24:25] op_sel_hi:[1,0]
    v_pk_mul_f32 v[128:129], v[128:129], v[24:25] op_sel_hi:[1,0]
    v_pk_mul_f32 v[130:131], v[130:131], v[24:25] op_sel_hi:[1,0]
    v_pk_mul_f32 v[132:133], v[132:133], v[24:25] op_sel_hi:[1,0]
    v_pk_mul_f32 v[134:135], v[134:135], v[24:25] op_sel_hi:[1,0]
    v_pk_mul_f32 v[136:137], v[136:137], v[24:25] op_sel_hi:[1,0]
    v_pk_mul_f32 v[138:139], v[138:139], v[24:25] op_sel_hi:[1,0]
    v_pk_mul_f32 v[140:141], v[140:141], v[24:25] op_sel_hi:[1,0]
    v_pk_mul_f32 v[142:143], v[142:143], v[24:25] op_sel_hi:[1,0]
    v_pk_mul_f32 v[144:145], v[144:145], v[24:25] op_sel_hi:[1,0]
    v_pk_mul_f32 v[146:147], v[146:147], v[24:25] op_sel_hi:[1,0]
    v_cvt_pk_bf16_f32 v44, v28, v29
    v_cvt_pk_bf16_f32 v45, v30, v31
    v_cvt_pk_bf16_f32 v46, v36, v37
    v_cvt_pk_bf16_f32 v47, v38, v39
    v_cvt_pk_bf16_f32 v48, v32, v33
    v_cvt_pk_bf16_f32 v49, v34, v35
    v_cvt_pk_bf16_f32 v50, v40, v41
    v_cvt_pk_bf16_f32 v51, v42, v43
    v_pk_add_f32 v[28:29], v[28:29], v[30:31]
    v_pk_add_f32 v[36:37], v[36:37], v[38:39]
    v_pk_add_f32 v[32:33], v[32:33], v[34:35]
    v_pk_add_f32 v[40:41], v[40:41], v[42:43]
    v_pk_add_f32 v[28:29], v[28:29], v[36:37]
    v_pk_add_f32 v[32:33], v[32:33], v[40:41]
    v_fma_f32 v10, v10, v22, v28
    v_fma_f32 v11, v11, v24, v32
    v_add_f32 v10, v10, v29
    v_add_f32 v11, v11, v33
    v_mfma_f32_16x16x32_bf16 v[84:87], v[52:55], v[44:47], v[84:87]
    v_mfma_f32_16x16x32_bf16 v[116:119], v[52:55], v[48:51], v[116:119]
    v_mfma_f32_16x16x32_bf16 v[88:91], v[56:59], v[44:47], v[88:91]
    v_mfma_f32_16x16x32_bf16 v[120:123], v[56:59], v[48:51], v[120:123]
    v_mfma_f32_16x16x32_bf16 v[92:95], v[60:63], v[44:47], v[92:95]
    v_mfma_f32_16x16x32_bf16 v[124:127], v[60:63], v[48:51], v[124:127]
    v_mfma_f32_16x16x32_bf16 v[96:99], v[64:67], v[44:47], v[96:99]
    v_mfma_f32_16x16x32_bf16 v[128:131], v[64:67], v[48:51], v[128:131]
    v_mfma_f32_16x16x32_bf16 v[100:103], v[68:71], v[44:47], v[100:103]
    v_mfma_f32_16x16x32_bf16 v[132:135], v[68:71], v[48:51], v[132:135]
    v_mfma_f32_16x16x32_bf16 v[104:107], v[72:75], v[44:47], v[104:107]
    v_mfma_f32_16x16x32_bf16 v[136:139], v[72:75], v[48:51], v[136:139]
    v_mfma_f32_16x16x32_bf16 v[108:111], v[76:79], v[44:47], v[108:111]
    v_mfma_f32_16x16x32_bf16 v[140:143], v[76:79], v[48:51], v[140:143]
    v_mfma_f32_16x16x32_bf16 v[112:115], v[80:83], v[44:47], v[112:115]
    v_mfma_f32_16x16x32_bf16 v[144:147], v[80:83], v[48:51], v[144:147]
    s_cmp_lt_u32 s32, 393216
    s_cbranch_scc1 L_loop
    v_bfe_u32 v198, v7, 4, 2
    v_lshlrev_b32 v199, 2, v198
    v_xor_b32 v199, v199, v7
    v_and_b32 v199, 15, v199
    v_and_b32 v200, 0x6000, v1
    v_lshl_add_u32 v200, v198, 8, v200
    v_lshl_add_u32 v194, v199, 4, v200
    v_xor_b32 v195, 16, v194
    v_xor_b32 v196, 32, v194
    v_xor_b32 v197, 48, v194
    v_xor_b32 v198, v198, v7
    v_and_b32 v198, 15, v198
    v_and_b32 v199, 0x7f00, v1
    v_add_u32 v199, 61440, v199
    v_lshl_add_u32 v198, v198, 4, v199
    v_xor_b32 v199, 64, v198
    v_xor_b32 v200, 128, v198
    v_xor_b32 v201, 192, v198
    s_lshl_b32 s38, s36, 2
    s_waitcnt vmcnt(5)
    s_add_u32 m0, s38, 98304
    s_add_u32 s39, s31, 4096
    buffer_load_dwordx4 v194, s[12:15], s39 offen offset:0 nt lds
    buffer_load_dwordx4 v195, s[12:15], s39 offen offset:1024 nt lds
    buffer_load_dwordx4 v196, s[12:15], s39 offen offset:2048 nt lds
    buffer_load_dwordx4 v197, s[12:15], s39 offen offset:3072 nt lds
    buffer_load_dwordx4 v[164:167], v4, s[16:19], s32 offen offset:0 nt
    buffer_load_dwordx4 v[168:171], v4, s[16:19], s32 offen offset:1024 nt
    buffer_load_dwordx4 v[172:175], v4, s[16:19], s32 offen offset:2048 nt
    buffer_load_dwordx4 v[176:179], v4, s[16:19], s32 offen offset:3072 nt
    s_add_u32 s31, s31, 32768
    s_add_u32 s32, s32, 32768
    s_waitcnt vmcnt(12)
    v_mfma_f32_16x16x32_bf16 v[28:31], a[32:35], a[0:3], 0
    v_mfma_f32_16x16x32_bf16 v[32:35], a[32:35], a[16:19], 0
    v_mfma_f32_16x16x32_bf16 v[28:31], a[36:39], a[4:7], v[28:31]
    v_mfma_f32_16x16x32_bf16 v[32:35], a[36:39], a[20:23], v[32:35]
    v_mfma_f32_16x16x32_bf16 v[28:31], a[40:43], a[8:11], v[28:31]
    v_mfma_f32_16x16x32_bf16 v[32:35], a[40:43], a[24:27], v[32:35]
    v_mfma_f32_16x16x32_bf16 v[28:31], a[44:47], a[12:15], v[28:31]
    v_mfma_f32_16x16x32_bf16 v[32:35], a[44:47], a[28:31], v[32:35]
    s_waitcnt vmcnt(8)
    v_perm_b32 v52, v152, v148, s29
    v_perm_b32 v53, v160, v156, s29
    v_perm_b32 v56, v152, v148, s30
    v_perm_b32 v57, v160, v156, s30
    v_perm_b32 v60, v153, v149, s29
    v_perm_b32 v61, v161, v157, s29
    v_perm_b32 v64, v153, v149, s30
    v_perm_b32 v65, v161, v157, s30
    v_perm_b32 v68, v154, v150, s29
    v_perm_b32 v69, v162, v158, s29
    v_perm_b32 v72, v154, v150, s30
    v_perm_b32 v73, v162, v158, s30
    v_perm_b32 v76, v155, v151, s29
    v_perm_b32 v77, v163, v159, s29
    v_perm_b32 v80, v155, v151, s30
    v_perm_b32 v81, v163, v159, s30
    s_waitcnt vmcnt(5)
    s_add_u32 m0, s38, 94208
    s_mov_b32 s39, s31
    buffer_load_dwordx4 v194, s[12:15], s39 offen offset:0 nt lds
    buffer_load_dwordx4 v195, s[12:15], s39 offen offset:1024 nt lds
    buffer_load_dwordx4 v196, s[12:15], s39 offen offset:2048 nt lds
    buffer_load_dwordx4 v197, s[12:15], s39 offen offset:3072 nt lds
    buffer_load_dwordx4 v[148:151], v3, s[16:19], s32 offen offset:0 nt
    buffer_load_dwordx4 v[152:155], v3, s[16:19], s32 offen offset:1024 nt
    buffer_load_dwordx4 v[156:159], v3, s[16:19], s32 offen offset:2048 nt
    buffer_load_dwordx4 v[160:163], v3, s[16:19], s32 offen offset:3072 nt
    s_waitcnt vmcnt(12)
    ds_read_b128 a[48:51], v198 offset:36864
    ds_read_b128 a[52:55], v199 offset:36864
    ds_read_b128 a[56:59], v200 offset:36864
    ds_read_b128 a[60:63], v201 offset:36864
    s_waitcnt vmcnt(8)
    v_perm_b32 v54, v168, v164, s29
    v_perm_b32 v55, v176, v172, s29
    v_perm_b32 v58, v168, v164, s30
    v_perm_b32 v59, v176, v172, s30
    v_perm_b32 v62, v169, v165, s29
    v_perm_b32 v63, v177, v173, s29
    v_perm_b32 v66, v169, v165, s30
    v_perm_b32 v67, v177, v173, s30
    v_perm_b32 v70, v170, v166, s29
    v_perm_b32 v71, v178, v174, s29
    v_perm_b32 v74, v170, v166, s30
    v_perm_b32 v75, v178, v174, s30
    v_perm_b32 v78, v171, v167, s29
    v_perm_b32 v79, v179, v175, s29
    v_perm_b32 v82, v171, v167, s30
    v_perm_b32 v83, v179, v175, s30
    s_waitcnt lgkmcnt(0)
    v_mfma_f32_16x16x32_bf16 v[36:39], a[48:51], a[0:3], 0
    v_mfma_f32_16x16x32_bf16 v[40:43], a[48:51], a[16:19], 0
    v_mfma_f32_16x16x32_bf16 v[36:39], a[52:55], a[4:7], v[36:39]
    v_mfma_f32_16x16x32_bf16 v[40:43], a[52:55], a[20:23], v[40:43]
    v_mfma_f32_16x16x32_bf16 v[36:39], a[56:59], a[8:11], v[36:39]
    v_mfma_f32_16x16x32_bf16 v[40:43], a[56:59], a[24:27], v[40:43]
    v_mfma_f32_16x16x32_bf16 v[36:39], a[60:63], a[12:15], v[36:39]
    v_mfma_f32_16x16x32_bf16 v[40:43], a[60:63], a[28:31], v[40:43]
    v_max3_f32 v12, v28, v29, v30
    s_nop 5
    v_max3_f32 v14, v31, v36, v37
    v_max3_f32 v12, v38, v39, v12
    v_max3_f32 v12, v12, v14, v8
    v_max3_f32 v13, v32, v33, v34
    v_max3_f32 v15, v35, v40, v41
    v_max3_f32 v13, v42, v43, v13
    v_max3_f32 v13, v13, v15, v9
    s_nop 1
    v_permlane32_swap_b32 v12, v13
    v_max_f32 v12, v12, v13
    v_mov_b32 v13, v12
    s_nop 1
    v_permlane16_swap_b32 v12, v13
    v_max_f32 v12, v12, v13
    v_mov_b32 v13, v12
    s_nop 1
    v_permlane32_swap_b32 v12, v13
    v_mul_f32 v20, s28, v12
    v_mul_f32 v21, s28, v13
    v_fma_f32 v22, v8, s28, -v20
    v_fma_f32 v24, v9, s28, -v21
    v_mov_b32 v8, v12
    v_mov_b32 v9, v13
    v_exp_f32 v22, v22
    v_exp_f32 v24, v24
    v_fma_f32 v28, v28, s28, -v20
    v_fma_f32 v29, v29, s28, -v20
    v_fma_f32 v30, v30, s28, -v20
    v_fma_f32 v31, v31, s28, -v20
    v_fma_f32 v36, v36, s28, -v20
    v_fma_f32 v37, v37, s28, -v20
    v_fma_f32 v38, v38, s28, -v20
    v_fma_f32 v39, v39, s28, -v20
    v_fma_f32 v32, v32, s28, -v21
    v_fma_f32 v33, v33, s28, -v21
    v_fma_f32 v34, v34, s28, -v21
    v_fma_f32 v35, v35, s28, -v21
    v_fma_f32 v40, v40, s28, -v21
    v_fma_f32 v41, v41, s28, -v21
    v_fma_f32 v42, v42, s28, -v21
    v_fma_f32 v43, v43, s28, -v21
    v_exp_f32 v28, v28
    v_exp_f32 v29, v29
    v_exp_f32 v30, v30
    v_exp_f32 v31, v31
    v_exp_f32 v36, v36
    v_exp_f32 v37, v37
    v_exp_f32 v38, v38
    v_exp_f32 v39, v39
    v_exp_f32 v32, v32
    v_exp_f32 v33, v33
    v_exp_f32 v34, v34
    v_exp_f32 v35, v35
    v_exp_f32 v40, v40
    v_exp_f32 v41, v41
    v_exp_f32 v42, v42
    v_exp_f32 v43, v43
    v_pk_mul_f32 v[84:85], v[84:85], v[22:23] op_sel_hi:[1,0]
    v_pk_mul_f32 v[86:87], v[86:87], v[22:23] op_sel_hi:[1,0]
    v_pk_mul_f32 v[88:89], v[88:89], v[22:23] op_sel_hi:[1,0]
    v_pk_mul_f32 v[90:91], v[90:91], v[22:23] op_sel_hi:[1,0]
    v_pk_mul_f32 v[92:93], v[92:93], v[22:23] op_sel_hi:[1,0]
    v_pk_mul_f32 v[94:95], v[94:95], v[22:23] op_sel_hi:[1,0]
    v_pk_mul_f32 v[96:97], v[96:97], v[22:23] op_sel_hi:[1,0]
    v_pk_mul_f32 v[98:99], v[98:99], v[22:23] op_sel_hi:[1,0]
    v_pk_mul_f32 v[100:101], v[100:101], v[22:23] op_sel_hi:[1,0]
    v_pk_mul_f32 v[102:103], v[102:103], v[22:23] op_sel_hi:[1,0]
    v_pk_mul_f32 v[104:105], v[104:105], v[22:23] op_sel_hi:[1,0]
    v_pk_mul_f32 v[106:107], v[106:107], v[22:23] op_sel_hi:[1,0]
    v_pk_mul_f32 v[108:109], v[108:109], v[22:23] op_sel_hi:[1,0]
    v_pk_mul_f32 v[110:111], v[110:111], v[22:23] op_sel_hi:[1,0]
    v_pk_mul_f32 v[112:113], v[112:113], v[22:23] op_sel_hi:[1,0]
    v_pk_mul_f32 v[114:115], v[114:115], v[22:23] op_sel_hi:[1,0]
    v_pk_mul_f32 v[116:117], v[116:117], v[24:25] op_sel_hi:[1,0]
    v_pk_mul_f32 v[118:119], v[118:119], v[24:25] op_sel_hi:[1,0]
    v_pk_mul_f32 v[120:121], v[120:121], v[24:25] op_sel_hi:[1,0]
    v_pk_mul_f32 v[122:123], v[122:123], v[24:25] op_sel_hi:[1,0]
    v_pk_mul_f32 v[124:125], v[124:125], v[24:25] op_sel_hi:[1,0]
    v_pk_mul_f32 v[126:127], v[126:127], v[24:25] op_sel_hi:[1,0]
    v_pk_mul_f32 v[128:129], v[128:129], v[24:25] op_sel_hi:[1,0]
    v_pk_mul_f32 v[130:131], v[130:131], v[24:25] op_sel_hi:[1,0]
    v_pk_mul_f32 v[132:133], v[132:133], v[24:25] op_sel_hi:[1,0]
    v_pk_mul_f32 v[134:135], v[134:135], v[24:25] op_sel_hi:[1,0]
    v_pk_mul_f32 v[136:137], v[136:137], v[24:25] op_sel_hi:[1,0]
    v_pk_mul_f32 v[138:139], v[138:139], v[24:25] op_sel_hi:[1,0]
    v_pk_mul_f32 v[140:141], v[140:141], v[24:25] op_sel_hi:[1,0]
    v_pk_mul_f32 v[142:143], v[142:143], v[24:25] op_sel_hi:[1,0]
    v_pk_mul_f32 v[144:145], v[144:145], v[24:25] op_sel_hi:[1,0]
    v_pk_mul_f32 v[146:147], v[146:147], v[24:25] op_sel_hi:[1,0]
    v_cvt_pk_bf16_f32 v44, v28, v29
    v_cvt_pk_bf16_f32 v45, v30, v31
    v_cvt_pk_bf16_f32 v46, v36, v37
    v_cvt_pk_bf16_f32 v47, v38, v39
    v_cvt_pk_bf16_f32 v48, v32, v33
    v_cvt_pk_bf16_f32 v49, v34, v35
    v_cvt_pk_bf16_f32 v50, v40, v41
    v_cvt_pk_bf16_f32 v51, v42, v43
    v_pk_add_f32 v[28:29], v[28:29], v[30:31]
    v_pk_add_f32 v[36:37], v[36:37], v[38:39]
    v_pk_add_f32 v[32:33], v[32:33], v[34:35]
    v_pk_add_f32 v[40:41], v[40:41], v[42:43]
    v_pk_add_f32 v[28:29], v[28:29], v[36:37]
    v_pk_add_f32 v[32:33], v[32:33], v[40:41]
    v_fma_f32 v10, v10, v22, v28
    v_fma_f32 v11, v11, v24, v32
    v_add_f32 v10, v10, v29
    v_add_f32 v11, v11, v33
    v_mfma_f32_16x16x32_bf16 v[84:87], v[52:55], v[44:47], v[84:87]
    v_mfma_f32_16x16x32_bf16 v[116:119], v[52:55], v[48:51], v[116:119]
    v_mfma_f32_16x16x32_bf16 v[88:91], v[56:59], v[44:47], v[88:91]
    v_mfma_f32_16x16x32_bf16 v[120:123], v[56:59], v[48:51], v[120:123]
    v_mfma_f32_16x16x32_bf16 v[92:95], v[60:63], v[44:47], v[92:95]
    v_mfma_f32_16x16x32_bf16 v[124:127], v[60:63], v[48:51], v[124:127]
    v_mfma_f32_16x16x32_bf16 v[96:99], v[64:67], v[44:47], v[96:99]
    v_mfma_f32_16x16x32_bf16 v[128:131], v[64:67], v[48:51], v[128:131]
    v_mfma_f32_16x16x32_bf16 v[100:103], v[68:71], v[44:47], v[100:103]
    v_mfma_f32_16x16x32_bf16 v[132:135], v[68:71], v[48:51], v[132:135]
    v_mfma_f32_16x16x32_bf16 v[104:107], v[72:75], v[44:47], v[104:107]
    v_mfma_f32_16x16x32_bf16 v[136:139], v[72:75], v[48:51], v[136:139]
    v_mfma_f32_16x16x32_bf16 v[108:111], v[76:79], v[44:47], v[108:111]
    v_mfma_f32_16x16x32_bf16 v[140:143], v[76:79], v[48:51], v[140:143]
    v_mfma_f32_16x16x32_bf16 v[112:115], v[80:83], v[44:47], v[112:115]
    v_mfma_f32_16x16x32_bf16 v[144:147], v[80:83], v[48:51], v[144:147]
    s_waitcnt vmcnt(5)
    s_add_u32 m0, s38, 98304
    s_add_u32 s39, s31, 4096
    buffer_load_dwordx4 v194, s[12:15], s39 offen offset:0 nt lds
    buffer_load_dwordx4 v195, s[12:15], s39 offen offset:1024 nt lds
    buffer_load_dwordx4 v196, s[12:15], s39 offen offset:2048 nt lds
    buffer_load_dwordx4 v197, s[12:15], s39 offen offset:3072 nt lds
    buffer_load_dwordx4 v[164:167], v4, s[16:19], s32 offen offset:0 nt
    buffer_load_dwordx4 v[168:171], v4, s[16:19], s32 offen offset:1024 nt
    buffer_load_dwordx4 v[172:175], v4, s[16:19], s32 offen offset:2048 nt
    buffer_load_dwordx4 v[176:179], v4, s[16:19], s32 offen offset:3072 nt
    s_add_u32 s31, s31, 32768
    s_add_u32 s32, s32, 32768
    s_waitcnt vmcnt(12)
    ds_read_b128 a[32:35], v198 offset:32768
    ds_read_b128 a[36:39], v199 offset:32768
    ds_read_b128 a[40:43], v200 offset:32768
    ds_read_b128 a[44:47], v201 offset:32768
    s_waitcnt vmcnt(8)
    v_perm_b32 v52, v152, v148, s29
    v_perm_b32 v53, v160, v156, s29
    v_perm_b32 v56, v152, v148, s30
    v_perm_b32 v57, v160, v156, s30
    v_perm_b32 v60, v153, v149, s29
    v_perm_b32 v61, v161, v157, s29
    v_perm_b32 v64, v153, v149, s30
    v_perm_b32 v65, v161, v157, s30
    v_perm_b32 v68, v154, v150, s29
    v_perm_b32 v69, v162, v158, s29
    v_perm_b32 v72, v154, v150, s30
    v_perm_b32 v73, v162, v158, s30
    v_perm_b32 v76, v155, v151, s29
    v_perm_b32 v77, v163, v159, s29
    v_perm_b32 v80, v155, v151, s30
    v_perm_b32 v81, v163, v159, s30
    s_waitcnt lgkmcnt(0)
    v_mfma_f32_16x16x32_bf16 v[28:31], a[32:35], a[0:3], 0
    v_mfma_f32_16x16x32_bf16 v[32:35], a[32:35], a[16:19], 0
    v_mfma_f32_16x16x32_bf16 v[28:31], a[36:39], a[4:7], v[28:31]
    v_mfma_f32_16x16x32_bf16 v[32:35], a[36:39], a[20:23], v[32:35]
    v_mfma_f32_16x16x32_bf16 v[28:31], a[40:43], a[8:11], v[28:31]
    v_mfma_f32_16x16x32_bf16 v[32:35], a[40:43], a[24:27], v[32:35]
    v_mfma_f32_16x16x32_bf16 v[28:31], a[44:47], a[12:15], v[28:31]
    v_mfma_f32_16x16x32_bf16 v[32:35], a[44:47], a[28:31], v[32:35]
    s_waitcnt vmcnt(5)
    s_add_u32 m0, s38, 94208
    s_mov_b32 s39, s31
    buffer_load_dwordx4 v194, s[12:15], s39 offen offset:0 nt lds
    buffer_load_dwordx4 v195, s[12:15], s39 offen offset:1024 nt lds
    buffer_load_dwordx4 v196, s[12:15], s39 offen offset:2048 nt lds
    buffer_load_dwordx4 v197, s[12:15], s39 offen offset:3072 nt lds
    buffer_load_dwordx4 v[148:151], v3, s[16:19], s32 offen offset:0 nt
    buffer_load_dwordx4 v[152:155], v3, s[16:19], s32 offen offset:1024 nt
    buffer_load_dwordx4 v[156:159], v3, s[16:19], s32 offen offset:2048 nt
    buffer_load_dwordx4 v[160:163], v3, s[16:19], s32 offen offset:3072 nt
    s_waitcnt vmcnt(12)
    ds_read_b128 a[48:51], v198 offset:36864
    ds_read_b128 a[52:55], v199 offset:36864
    ds_read_b128 a[56:59], v200 offset:36864
    ds_read_b128 a[60:63], v201 offset:36864
    s_waitcnt vmcnt(8)
    v_perm_b32 v54, v168, v164, s29
    v_perm_b32 v55, v176, v172, s29
    v_perm_b32 v58, v168, v164, s30
    v_perm_b32 v59, v176, v172, s30
    v_perm_b32 v62, v169, v165, s29
    v_perm_b32 v63, v177, v173, s29
    v_perm_b32 v66, v169, v165, s30
    v_perm_b32 v67, v177, v173, s30
    v_perm_b32 v70, v170, v166, s29
    v_perm_b32 v71, v178, v174, s29
    v_perm_b32 v74, v170, v166, s30
    v_perm_b32 v75, v178, v174, s30
    v_perm_b32 v78, v171, v167, s29
    v_perm_b32 v79, v179, v175, s29
    v_perm_b32 v82, v171, v167, s30
    v_perm_b32 v83, v179, v175, s30
    s_waitcnt lgkmcnt(0)
    v_mfma_f32_16x16x32_bf16 v[36:39], a[48:51], a[0:3], 0
    v_mfma_f32_16x16x32_bf16 v[40:43], a[48:51], a[16:19], 0
    v_mfma_f32_16x16x32_bf16 v[36:39], a[52:55], a[4:7], v[36:39]
    v_mfma_f32_16x16x32_bf16 v[40:43], a[52:55], a[20:23], v[40:43]
    v_mfma_f32_16x16x32_bf16 v[36:39], a[56:59], a[8:11], v[36:39]
    v_mfma_f32_16x16x32_bf16 v[40:43], a[56:59], a[24:27], v[40:43]
    v_mfma_f32_16x16x32_bf16 v[36:39], a[60:63], a[12:15], v[36:39]
    v_mfma_f32_16x16x32_bf16 v[40:43], a[60:63], a[28:31], v[40:43]
    v_max3_f32 v12, v28, v29, v30
    s_nop 5
    v_max3_f32 v14, v31, v36, v37
    v_max3_f32 v12, v38, v39, v12
    v_max3_f32 v12, v12, v14, v8
    v_max3_f32 v13, v32, v33, v34
    v_max3_f32 v15, v35, v40, v41
    v_max3_f32 v13, v42, v43, v13
    v_max3_f32 v13, v13, v15, v9
    s_nop 1
    v_permlane32_swap_b32 v12, v13
    v_max_f32 v12, v12, v13
    v_mov_b32 v13, v12
    s_nop 1
    v_permlane16_swap_b32 v12, v13
    v_max_f32 v12, v12, v13
    v_mov_b32 v13, v12
    s_nop 1
    v_permlane32_swap_b32 v12, v13
    v_mul_f32 v20, s28, v12
    v_mul_f32 v21, s28, v13
    v_fma_f32 v22, v8, s28, -v20
    v_fma_f32 v24, v9, s28, -v21
    v_mov_b32 v8, v12
    v_mov_b32 v9, v13
    v_exp_f32 v22, v22
    v_exp_f32 v24, v24
    v_fma_f32 v28, v28, s28, -v20
    v_fma_f32 v29, v29, s28, -v20
    v_fma_f32 v30, v30, s28, -v20
    v_fma_f32 v31, v31, s28, -v20
    v_fma_f32 v36, v36, s28, -v20
    v_fma_f32 v37, v37, s28, -v20
    v_fma_f32 v38, v38, s28, -v20
    v_fma_f32 v39, v39, s28, -v20
    v_fma_f32 v32, v32, s28, -v21
    v_fma_f32 v33, v33, s28, -v21
    v_fma_f32 v34, v34, s28, -v21
    v_fma_f32 v35, v35, s28, -v21
    v_fma_f32 v40, v40, s28, -v21
    v_fma_f32 v41, v41, s28, -v21
    v_fma_f32 v42, v42, s28, -v21
    v_fma_f32 v43, v43, s28, -v21
    v_exp_f32 v28, v28
    v_exp_f32 v29, v29
    v_exp_f32 v30, v30
    v_exp_f32 v31, v31
    v_exp_f32 v36, v36
    v_exp_f32 v37, v37
    v_exp_f32 v38, v38
    v_exp_f32 v39, v39
    v_exp_f32 v32, v32
    v_exp_f32 v33, v33
    v_exp_f32 v34, v34
    v_exp_f32 v35, v35
    v_exp_f32 v40, v40
    v_exp_f32 v41, v41
    v_exp_f32 v42, v42
    v_exp_f32 v43, v43
    v_pk_mul_f32 v[84:85], v[84:85], v[22:23] op_sel_hi:[1,0]
    v_pk_mul_f32 v[86:87], v[86:87], v[22:23] op_sel_hi:[1,0]
    v_pk_mul_f32 v[88:89], v[88:89], v[22:23] op_sel_hi:[1,0]
    v_pk_mul_f32 v[90:91], v[90:91], v[22:23] op_sel_hi:[1,0]
    v_pk_mul_f32 v[92:93], v[92:93], v[22:23] op_sel_hi:[1,0]
    v_pk_mul_f32 v[94:95], v[94:95], v[22:23] op_sel_hi:[1,0]
    v_pk_mul_f32 v[96:97], v[96:97], v[22:23] op_sel_hi:[1,0]
    v_pk_mul_f32 v[98:99], v[98:99], v[22:23] op_sel_hi:[1,0]
    v_pk_mul_f32 v[100:101], v[100:101], v[22:23] op_sel_hi:[1,0]
    v_pk_mul_f32 v[102:103], v[102:103], v[22:23] op_sel_hi:[1,0]
    v_pk_mul_f32 v[104:105], v[104:105], v[22:23] op_sel_hi:[1,0]
    v_pk_mul_f32 v[106:107], v[106:107], v[22:23] op_sel_hi:[1,0]
    v_pk_mul_f32 v[108:109], v[108:109], v[22:23] op_sel_hi:[1,0]
    v_pk_mul_f32 v[110:111], v[110:111], v[22:23] op_sel_hi:[1,0]
    v_pk_mul_f32 v[112:113], v[112:113], v[22:23] op_sel_hi:[1,0]
    v_pk_mul_f32 v[114:115], v[114:115], v[22:23] op_sel_hi:[1,0]
    v_pk_mul_f32 v[116:117], v[116:117], v[24:25] op_sel_hi:[1,0]
    v_pk_mul_f32 v[118:119], v[118:119], v[24:25] op_sel_hi:[1,0]
    v_pk_mul_f32 v[120:121], v[120:121], v[24:25] op_sel_hi:[1,0]
    v_pk_mul_f32 v[122:123], v[122:123], v[24:25] op_sel_hi:[1,0]
    v_pk_mul_f32 v[124:125], v[124:125], v[24:25] op_sel_hi:[1,0]
    v_pk_mul_f32 v[126:127], v[126:127], v[24:25] op_sel_hi:[1,0]
    v_pk_mul_f32 v[128:129], v[128:129], v[24:25] op_sel_hi:[1,0]
    v_pk_mul_f32 v[130:131], v[130:131], v[24:25] op_sel_hi:[1,0]
    v_pk_mul_f32 v[132:133], v[132:133], v[24:25] op_sel_hi:[1,0]
    v_pk_mul_f32 v[134:135], v[134:135], v[24:25] op_sel_hi:[1,0]
    v_pk_mul_f32 v[136:137], v[136:137], v[24:25] op_sel_hi:[1,0]
    v_pk_mul_f32 v[138:139], v[138:139], v[24:25] op_sel_hi:[1,0]
    v_pk_mul_f32 v[140:141], v[140:141], v[24:25] op_sel_hi:[1,0]
    v_pk_mul_f32 v[142:143], v[142:143], v[24:25] op_sel_hi:[1,0]
    v_pk_mul_f32 v[144:145], v[144:145], v[24:25] op_sel_hi:[1,0]
    v_pk_mul_f32 v[146:147], v[146:147], v[24:25] op_sel_hi:[1,0]
    v_cvt_pk_bf16_f32 v44, v28, v29
    v_cvt_pk_bf16_f32 v45, v30, v31
    v_cvt_pk_bf16_f32 v46, v36, v37
    v_cvt_pk_bf16_f32 v47, v38, v39
    v_cvt_pk_bf16_f32 v48, v32, v33
    v_cvt_pk_bf16_f32 v49, v34, v35
    v_cvt_pk_bf16_f32 v50, v40, v41
    v_cvt_pk_bf16_f32 v51, v42, v43
    v_pk_add_f32 v[28:29], v[28:29], v[30:31]
    v_pk_add_f32 v[36:37], v[36:37], v[38:39]
    v_pk_add_f32 v[32:33], v[32:33], v[34:35]
    v_pk_add_f32 v[40:41], v[40:41], v[42:43]
    v_pk_add_f32 v[28:29], v[28:29], v[36:37]
    v_pk_add_f32 v[32:33], v[32:33], v[40:41]
    v_fma_f32 v10, v10, v22, v28
    v_fma_f32 v11, v11, v24, v32
    v_add_f32 v10, v10, v29
    v_add_f32 v11, v11, v33
    v_mfma_f32_16x16x32_bf16 v[84:87], v[52:55], v[44:47], v[84:87]
    v_mfma_f32_16x16x32_bf16 v[116:119], v[52:55], v[48:51], v[116:119]
    v_mfma_f32_16x16x32_bf16 v[88:91], v[56:59], v[44:47], v[88:91]
    v_mfma_f32_16x16x32_bf16 v[120:123], v[56:59], v[48:51], v[120:123]
    v_mfma_f32_16x16x32_bf16 v[92:95], v[60:63], v[44:47], v[92:95]
    v_mfma_f32_16x16x32_bf16 v[124:127], v[60:63], v[48:51], v[124:127]
    v_mfma_f32_16x16x32_bf16 v[96:99], v[64:67], v[44:47], v[96:99]
    v_mfma_f32_16x16x32_bf16 v[128:131], v[64:67], v[48:51], v[128:131]
    v_mfma_f32_16x16x32_bf16 v[100:103], v[68:71], v[44:47], v[100:103]
    v_mfma_f32_16x16x32_bf16 v[132:135], v[68:71], v[48:51], v[132:135]
    v_mfma_f32_16x16x32_bf16 v[104:107], v[72:75], v[44:47], v[104:107]
    v_mfma_f32_16x16x32_bf16 v[136:139], v[72:75], v[48:51], v[136:139]
    v_mfma_f32_16x16x32_bf16 v[108:111], v[76:79], v[44:47], v[108:111]
    v_mfma_f32_16x16x32_bf16 v[140:143], v[76:79], v[48:51], v[140:143]
    v_mfma_f32_16x16x32_bf16 v[112:115], v[80:83], v[44:47], v[112:115]
    v_mfma_f32_16x16x32_bf16 v[144:147], v[80:83], v[48:51], v[144:147]
    s_waitcnt vmcnt(5)
    s_add_u32 m0, s38, 98304
    s_add_u32 s39, s31, 4096
    buffer_load_dwordx4 v194, s[12:15], s39 offen offset:0 nt lds
    buffer_load_dwordx4 v195, s[12:15], s39 offen offset:1024 nt lds
    buffer_load_dwordx4 v196, s[12:15], s39 offen offset:2048 nt lds
    buffer_load_dwordx4 v197, s[12:15], s39 offen offset:3072 nt lds
    buffer_load_dwordx4 v[164:167], v4, s[16:19], s32 offen offset:0 nt
    buffer_load_dwordx4 v[168:171], v4, s[16:19], s32 offen offset:1024 nt
    buffer_load_dwordx4 v[172:175], v4, s[16:19], s32 offen offset:2048 nt
    buffer_load_dwordx4 v[176:179], v4, s[16:19], s32 offen offset:3072 nt
    s_add_u32 s31, s31, 32768
    s_add_u32 s32, s32, 32768
    s_waitcnt vmcnt(12)
    ds_read_b128 a[32:35], v198 offset:32768
    ds_read_b128 a[36:39], v199 offset:32768
    ds_read_b128 a[40:43], v200 offset:32768
    ds_read_b128 a[44:47], v201 offset:32768
    s_waitcnt vmcnt(8)
    v_perm_b32 v52, v152, v148, s29
    v_perm_b32 v53, v160, v156, s29
    v_perm_b32 v56, v152, v148, s30
    v_perm_b32 v57, v160, v156, s30
    v_perm_b32 v60, v153, v149, s29
    v_perm_b32 v61, v161, v157, s29
    v_perm_b32 v64, v153, v149, s30
    v_perm_b32 v65, v161, v157, s30
    v_perm_b32 v68, v154, v150, s29
    v_perm_b32 v69, v162, v158, s29
    v_perm_b32 v72, v154, v150, s30
    v_perm_b32 v73, v162, v158, s30
    v_perm_b32 v76, v155, v151, s29
    v_perm_b32 v77, v163, v159, s29
    v_perm_b32 v80, v155, v151, s30
    v_perm_b32 v81, v163, v159, s30
    s_waitcnt lgkmcnt(0)
    v_mfma_f32_16x16x32_bf16 v[28:31], a[32:35], a[0:3], 0
    v_mfma_f32_16x16x32_bf16 v[32:35], a[32:35], a[16:19], 0
    v_mfma_f32_16x16x32_bf16 v[28:31], a[36:39], a[4:7], v[28:31]
    v_mfma_f32_16x16x32_bf16 v[32:35], a[36:39], a[20:23], v[32:35]
    v_mfma_f32_16x16x32_bf16 v[28:31], a[40:43], a[8:11], v[28:31]
    v_mfma_f32_16x16x32_bf16 v[32:35], a[40:43], a[24:27], v[32:35]
    v_mfma_f32_16x16x32_bf16 v[28:31], a[44:47], a[12:15], v[28:31]
    v_mfma_f32_16x16x32_bf16 v[32:35], a[44:47], a[28:31], v[32:35]
    s_waitcnt vmcnt(5)
    s_lshl_b32 s38, s36, 2
    s_add_u32 m0, s38, 61440
    s_nop 0
    buffer_load_dwordx4 v194, s[12:15], s31 offen offset:0 nt lds
    buffer_load_dwordx4 v195, s[12:15], s31 offen offset:1024 nt lds
    buffer_load_dwordx4 v196, s[12:15], s31 offen offset:2048 nt lds
    buffer_load_dwordx4 v197, s[12:15], s31 offen offset:3072 nt lds
    s_add_u32 m0, s38, 65536
    s_add_u32 s31, s31, 4096
    buffer_load_dwordx4 v194, s[12:15], s31 offen offset:0 nt lds
    buffer_load_dwordx4 v195, s[12:15], s31 offen offset:1024 nt lds
    buffer_load_dwordx4 v196, s[12:15], s31 offen offset:2048 nt lds
    buffer_load_dwordx4 v197, s[12:15], s31 offen offset:3072 nt lds
    s_waitcnt vmcnt(12)
    ds_read_b128 a[48:51], v198 offset:36864
    ds_read_b128 a[52:55], v199 offset:36864
    ds_read_b128 a[56:59], v200 offset:36864
    ds_read_b128 a[60:63], v201 offset:36864
    s_waitcnt vmcnt(8)
    v_perm_b32 v54, v168, v164, s29
    v_perm_b32 v55, v176, v172, s29
    v_perm_b32 v58, v168, v164, s30
    v_perm_b32 v59, v176, v172, s30
    v_perm_b32 v62, v169, v165, s29
    v_perm_b32 v63, v177, v173, s29
    v_perm_b32 v66, v169, v165, s30
    v_perm_b32 v67, v177, v173, s30
    v_perm_b32 v70, v170, v166, s29
    v_perm_b32 v71, v178, v174, s29
    v_perm_b32 v74, v170, v166, s30
    v_perm_b32 v75, v178, v174, s30
    v_perm_b32 v78, v171, v167, s29
    v_perm_b32 v79, v179, v175, s29
    v_perm_b32 v82, v171, v167, s30
    v_perm_b32 v83, v179, v175, s30
    s_waitcnt lgkmcnt(0)
    v_mfma_f32_16x16x32_bf16 v[36:39], a[48:51], a[0:3], 0
    v_mfma_f32_16x16x32_bf16 v[40:43], a[48:51], a[16:19], 0
    v_mfma_f32_16x16x32_bf16 v[36:39], a[52:55], a[4:7], v[36:39]
    v_mfma_f32_16x16x32_bf16 v[40:43], a[52:55], a[20:23], v[40:43]
    v_mfma_f32_16x16x32_bf16 v[36:39], a[56:59], a[8:11], v[36:39]
    v_mfma_f32_16x16x32_bf16 v[40:43], a[56:59], a[24:27], v[40:43]
    v_mfma_f32_16x16x32_bf16 v[36:39], a[60:63], a[12:15], v[36:39]
    v_mfma_f32_16x16x32_bf16 v[40:43], a[60:63], a[28:31], v[40:43]
    v_max3_f32 v12, v28, v29, v30
    s_nop 5
    v_max3_f32 v14, v31, v36, v37
    v_max3_f32 v12, v38, v39, v12
    v_max3_f32 v12, v12, v14, v8
    v_max3_f32 v13, v32, v33, v34
    v_max3_f32 v15, v35, v40, v41
    v_max3_f32 v13, v42, v43, v13
    v_max3_f32 v13, v13, v15, v9
    s_nop 1
    v_permlane32_swap_b32 v12, v13
    v_max_f32 v12, v12, v13
    v_mov_b32 v13, v12
    s_nop 1
    v_permlane16_swap_b32 v12, v13
    v_max_f32 v12, v12, v13
    v_mov_b32 v13, v12
    s_nop 1
    v_permlane32_swap_b32 v12, v13
    v_mul_f32 v20, s28, v12
    v_mul_f32 v21, s28, v13
    v_fma_f32 v22, v8, s28, -v20
    v_fma_f32 v24, v9, s28, -v21
    v_mov_b32 v8, v12
    v_mov_b32 v9, v13
    v_exp_f32 v22, v22
    v_exp_f32 v24, v24
    v_fma_f32 v28, v28, s28, -v20
    v_fma_f32 v29, v29, s28, -v20
    v_fma_f32 v30, v30, s28, -v20
    v_fma_f32 v31, v31, s28, -v20
    v_fma_f32 v36, v36, s28, -v20
    v_fma_f32 v37, v37, s28, -v20
    v_fma_f32 v38, v38, s28, -v20
    v_fma_f32 v39, v39, s28, -v20
    v_fma_f32 v32, v32, s28, -v21
    v_fma_f32 v33, v33, s28, -v21
    v_fma_f32 v34, v34, s28, -v21
    v_fma_f32 v35, v35, s28, -v21
    v_fma_f32 v40, v40, s28, -v21
    v_fma_f32 v41, v41, s28, -v21
    v_fma_f32 v42, v42, s28, -v21
    v_fma_f32 v43, v43, s28, -v21
    v_exp_f32 v28, v28
    v_exp_f32 v29, v29
    v_exp_f32 v30, v30
    v_exp_f32 v31, v31
    v_exp_f32 v36, v36
    v_exp_f32 v37, v37
    v_exp_f32 v38, v38
    v_exp_f32 v39, v39
    v_exp_f32 v32, v32
    v_exp_f32 v33, v33
    v_exp_f32 v34, v34
    v_exp_f32 v35, v35
    v_exp_f32 v40, v40
    v_exp_f32 v41, v41
    v_exp_f32 v42, v42
    v_exp_f32 v43, v43
    v_pk_mul_f32 v[84:85], v[84:85], v[22:23] op_sel_hi:[1,0]
    v_pk_mul_f32 v[86:87], v[86:87], v[22:23] op_sel_hi:[1,0]
    v_pk_mul_f32 v[88:89], v[88:89], v[22:23] op_sel_hi:[1,0]
    v_pk_mul_f32 v[90:91], v[90:91], v[22:23] op_sel_hi:[1,0]
    v_pk_mul_f32 v[92:93], v[92:93], v[22:23] op_sel_hi:[1,0]
    v_pk_mul_f32 v[94:95], v[94:95], v[22:23] op_sel_hi:[1,0]
    v_pk_mul_f32 v[96:97], v[96:97], v[22:23] op_sel_hi:[1,0]
    v_pk_mul_f32 v[98:99], v[98:99], v[22:23] op_sel_hi:[1,0]
    v_pk_mul_f32 v[100:101], v[100:101], v[22:23] op_sel_hi:[1,0]
    v_pk_mul_f32 v[102:103], v[102:103], v[22:23] op_sel_hi:[1,0]
    v_pk_mul_f32 v[104:105], v[104:105], v[22:23] op_sel_hi:[1,0]
    v_pk_mul_f32 v[106:107], v[106:107], v[22:23] op_sel_hi:[1,0]
    v_pk_mul_f32 v[108:109], v[108:109], v[22:23] op_sel_hi:[1,0]
    v_pk_mul_f32 v[110:111], v[110:111], v[22:23] op_sel_hi:[1,0]
    v_pk_mul_f32 v[112:113], v[112:113], v[22:23] op_sel_hi:[1,0]
    v_pk_mul_f32 v[114:115], v[114:115], v[22:23] op_sel_hi:[1,0]
    v_pk_mul_f32 v[116:117], v[116:117], v[24:25] op_sel_hi:[1,0]
    v_pk_mul_f32 v[118:119], v[118:119], v[24:25] op_sel_hi:[1,0]
    v_pk_mul_f32 v[120:121], v[120:121], v[24:25] op_sel_hi:[1,0]
    v_pk_mul_f32 v[122:123], v[122:123], v[24:25] op_sel_hi:[1,0]
    v_pk_mul_f32 v[124:125], v[124:125], v[24:25] op_sel_hi:[1,0]
    v_pk_mul_f32 v[126:127], v[126:127], v[24:25] op_sel_hi:[1,0]
    v_pk_mul_f32 v[128:129], v[128:129], v[24:25] op_sel_hi:[1,0]
    v_pk_mul_f32 v[130:131], v[130:131], v[24:25] op_sel_hi:[1,0]
    v_pk_mul_f32 v[132:133], v[132:133], v[24:25] op_sel_hi:[1,0]
    v_pk_mul_f32 v[134:135], v[134:135], v[24:25] op_sel_hi:[1,0]
    v_pk_mul_f32 v[136:137], v[136:137], v[24:25] op_sel_hi:[1,0]
    v_pk_mul_f32 v[138:139], v[138:139], v[24:25] op_sel_hi:[1,0]
    v_pk_mul_f32 v[140:141], v[140:141], v[24:25] op_sel_hi:[1,0]
    v_pk_mul_f32 v[142:143], v[142:143], v[24:25] op_sel_hi:[1,0]
    v_pk_mul_f32 v[144:145], v[144:145], v[24:25] op_sel_hi:[1,0]
    v_pk_mul_f32 v[146:147], v[146:147], v[24:25] op_sel_hi:[1,0]
    v_cvt_pk_bf16_f32 v44, v28, v29
    v_cvt_pk_bf16_f32 v45, v30, v31
    v_cvt_pk_bf16_f32 v46, v36, v37
    v_cvt_pk_bf16_f32 v47, v38, v39
    v_cvt_pk_bf16_f32 v48, v32, v33
    v_cvt_pk_bf16_f32 v49, v34, v35
    v_cvt_pk_bf16_f32 v50, v40, v41
    v_cvt_pk_bf16_f32 v51, v42, v43
    v_pk_add_f32 v[28:29], v[28:29], v[30:31]
    v_pk_add_f32 v[36:37], v[36:37], v[38:39]
    v_pk_add_f32 v[32:33], v[32:33], v[34:35]
    v_pk_add_f32 v[40:41], v[40:41], v[42:43]
    v_pk_add_f32 v[28:29], v[28:29], v[36:37]
    v_pk_add_f32 v[32:33], v[32:33], v[40:41]
    v_fma_f32 v10, v10, v22, v28
    v_fma_f32 v11, v11, v24, v32
    v_add_f32 v10, v10, v29
    v_add_f32 v11, v11, v33
    v_mfma_f32_16x16x32_bf16 v[84:87], v[52:55], v[44:47], v[84:87]
    v_mfma_f32_16x16x32_bf16 v[116:119], v[52:55], v[48:51], v[116:119]
    v_mfma_f32_16x16x32_bf16 v[88:91], v[56:59], v[44:47], v[88:91]
    v_mfma_f32_16x16x32_bf16 v[120:123], v[56:59], v[48:51], v[120:123]
    v_mfma_f32_16x16x32_bf16 v[92:95], v[60:63], v[44:47], v[92:95]
    v_mfma_f32_16x16x32_bf16 v[124:127], v[60:63], v[48:51], v[124:127]
    v_mfma_f32_16x16x32_bf16 v[96:99], v[64:67], v[44:47], v[96:99]
    v_mfma_f32_16x16x32_bf16 v[128:131], v[64:67], v[48:51], v[128:131]
    v_mfma_f32_16x16x32_bf16 v[100:103], v[68:71], v[44:47], v[100:103]
    v_mfma_f32_16x16x32_bf16 v[132:135], v[68:71], v[48:51], v[132:135]
    v_mfma_f32_16x16x32_bf16 v[104:107], v[72:75], v[44:47], v[104:107]
    v_mfma_f32_16x16x32_bf16 v[136:139], v[72:75], v[48:51], v[136:139]
    v_mfma_f32_16x16x32_bf16 v[108:111], v[76:79], v[44:47], v[108:111]
    v_mfma_f32_16x16x32_bf16 v[140:143], v[76:79], v[48:51], v[140:143]
    v_mfma_f32_16x16x32_bf16 v[112:115], v[80:83], v[44:47], v[112:115]
    v_mfma_f32_16x16x32_bf16 v[144:147], v[80:83], v[48:51], v[144:147]
    s_waitcnt vmcnt(5)
    buffer_load_dwordx4 v[148:151], v3, s[16:19], s32 offen offset:0 nt
    buffer_load_dwordx4 v[152:155], v3, s[16:19], s32 offen offset:1024 nt
    buffer_load_dwordx4 v[156:159], v3, s[16:19], s32 offen offset:2048 nt
    buffer_load_dwordx4 v[160:163], v3, s[16:19], s32 offen offset:3072 nt
    buffer_load_dwordx4 v[164:167], v4, s[16:19], s32 offen offset:0 nt
    buffer_load_dwordx4 v[168:171], v4, s[16:19], s32 offen offset:1024 nt
    buffer_load_dwordx4 v[172:175], v4, s[16:19], s32 offen offset:2048 nt
    buffer_load_dwordx4 v[176:179], v4, s[16:19], s32 offen offset:3072 nt
    v_lshlrev_b32 v189, 3, v7
    v_add_u32 v180, v26, v189
    v_lshrrev_b32 v190, 3, v26
    v_add_u32 v181, 2048, v180
    v_add_u32 v182, 16384, v180
    v_add_u32 v183, 18432, v180
    v_add_u32 v184, 32768, v180
    v_add_u32 v185, 34816, v180
    v_and_b32 v190, 0x600, v190
    v_xor_b32 v186, 4096, v180
    v_xor_b32 v187, 8192, v180
    v_xor_b32 v188, 12288, v180
    v_add_u32 v189, v189, v190
    v_and_b32 v190, 0x678, v189
    v_xor_b32 v191, 512, v190
    v_xor_b32 v192, 1280, v190
    v_xor_b32 v193, 1792, v190
    s_waitcnt vmcnt(12)
    ds_read_b128 a[32:35], v198 offset:0
    ds_read_b128 a[36:39], v199 offset:0
    ds_read_b128 a[40:43], v200 offset:0
    ds_read_b128 a[44:47], v201 offset:0
    s_waitcnt vmcnt(8)
    ds_read_b128 a[48:51], v198 offset:4096
    ds_read_b128 a[52:55], v199 offset:4096
    ds_read_b128 a[56:59], v200 offset:4096
    ds_read_b128 a[60:63], v201 offset:4096
    s_waitcnt lgkmcnt(4)
    v_mfma_f32_16x16x32_bf16 v[28:31], a[32:35], a[0:3], 0
    v_mfma_f32_16x16x32_bf16 v[32:35], a[32:35], a[16:19], 0
    v_mfma_f32_16x16x32_bf16 v[28:31], a[36:39], a[4:7], v[28:31]
    v_mfma_f32_16x16x32_bf16 v[32:35], a[36:39], a[20:23], v[32:35]
    v_mfma_f32_16x16x32_bf16 v[28:31], a[40:43], a[8:11], v[28:31]
    v_mfma_f32_16x16x32_bf16 v[32:35], a[40:43], a[24:27], v[32:35]
    v_mfma_f32_16x16x32_bf16 v[28:31], a[44:47], a[12:15], v[28:31]
    v_mfma_f32_16x16x32_bf16 v[32:35], a[44:47], a[28:31], v[32:35]
    s_waitcnt lgkmcnt(0)
    v_mfma_f32_16x16x32_bf16 v[36:39], a[48:51], a[0:3], 0
    v_mfma_f32_16x16x32_bf16 v[40:43], a[48:51], a[16:19], 0
    v_mfma_f32_16x16x32_bf16 v[36:39], a[52:55], a[4:7], v[36:39]
    v_mfma_f32_16x16x32_bf16 v[40:43], a[52:55], a[20:23], v[40:43]
    v_mfma_f32_16x16x32_bf16 v[36:39], a[56:59], a[8:11], v[36:39]
    v_mfma_f32_16x16x32_bf16 v[40:43], a[56:59], a[24:27], v[40:43]
    v_mfma_f32_16x16x32_bf16 v[36:39], a[60:63], a[12:15], v[36:39]
    v_mfma_f32_16x16x32_bf16 v[40:43], a[60:63], a[28:31], v[40:43]
    v_max3_f32 v12, v28, v29, v30
    s_nop 5
    v_max3_f32 v14, v31, v36, v37
    v_max3_f32 v12, v38, v39, v12
    v_max3_f32 v12, v12, v14, v8
    v_max3_f32 v13, v32, v33, v34
    v_max3_f32 v15, v35, v40, v41
    v_max3_f32 v13, v42, v43, v13
    v_max3_f32 v13, v13, v15, v9
    s_nop 1
    v_permlane32_swap_b32 v12, v13
    v_max_f32 v12, v12, v13
    v_mov_b32 v13, v12
    s_nop 1
    v_permlane16_swap_b32 v12, v13
    v_max_f32 v12, v12, v13
    v_mov_b32 v13, v12
    s_nop 1
    v_permlane32_swap_b32 v12, v13
    v_mul_f32 v20, s28, v12
    v_mul_f32 v21, s28, v13
    v_fma_f32 v22, v8, s28, -v20
    v_fma_f32 v24, v9, s28, -v21
    v_mov_b32 v8, v12
    v_mov_b32 v9, v13
    v_exp_f32 v22, v22
    v_exp_f32 v24, v24
    v_fma_f32 v28, v28, s28, -v20
    v_fma_f32 v29, v29, s28, -v20
    v_fma_f32 v30, v30, s28, -v20
    v_fma_f32 v31, v31, s28, -v20
    v_fma_f32 v36, v36, s28, -v20
    v_fma_f32 v37, v37, s28, -v20
    v_fma_f32 v38, v38, s28, -v20
    v_fma_f32 v39, v39, s28, -v20
    v_fma_f32 v32, v32, s28, -v21
    v_fma_f32 v33, v33, s28, -v21
    v_fma_f32 v34, v34, s28, -v21
    v_fma_f32 v35, v35, s28, -v21
    v_fma_f32 v40, v40, s28, -v21
    v_fma_f32 v41, v41, s28, -v21
    v_fma_f32 v42, v42, s28, -v21
    v_fma_f32 v43, v43, s28, -v21
    v_exp_f32 v28, v28
    v_exp_f32 v29, v29
    v_exp_f32 v30, v30
    v_exp_f32 v31, v31
    v_exp_f32 v36, v36
    v_exp_f32 v37, v37
    v_exp_f32 v38, v38
    v_exp_f32 v39, v39
    v_exp_f32 v32, v32
    v_exp_f32 v33, v33
    v_exp_f32 v34, v34
    v_exp_f32 v35, v35
    v_exp_f32 v40, v40
    v_exp_f32 v41, v41
    v_exp_f32 v42, v42
    v_exp_f32 v43, v43
    v_pk_mul_f32 v[84:85], v[84:85], v[22:23] op_sel_hi:[1,0]
    v_pk_mul_f32 v[86:87], v[86:87], v[22:23] op_sel_hi:[1,0]
    v_pk_mul_f32 v[88:89], v[88:89], v[22:23] op_sel_hi:[1,0]
    v_pk_mul_f32 v[90:91], v[90:91], v[22:23] op_sel_hi:[1,0]
    v_pk_mul_f32 v[92:93], v[92:93], v[22:23] op_sel_hi:[1,0]
    v_pk_mul_f32 v[94:95], v[94:95], v[22:23] op_sel_hi:[1,0]
    v_pk_mul_f32 v[96:97], v[96:97], v[22:23] op_sel_hi:[1,0]
    v_pk_mul_f32 v[98:99], v[98:99], v[22:23] op_sel_hi:[1,0]
    v_pk_mul_f32 v[100:101], v[100:101], v[22:23] op_sel_hi:[1,0]
    v_pk_mul_f32 v[102:103], v[102:103], v[22:23] op_sel_hi:[1,0]
    v_pk_mul_f32 v[104:105], v[104:105], v[22:23] op_sel_hi:[1,0]
    v_pk_mul_f32 v[106:107], v[106:107], v[22:23] op_sel_hi:[1,0]
    v_pk_mul_f32 v[108:109], v[108:109], v[22:23] op_sel_hi:[1,0]
    v_pk_mul_f32 v[110:111], v[110:111], v[22:23] op_sel_hi:[1,0]
    v_pk_mul_f32 v[112:113], v[112:113], v[22:23] op_sel_hi:[1,0]
    v_pk_mul_f32 v[114:115], v[114:115], v[22:23] op_sel_hi:[1,0]
    v_pk_mul_f32 v[116:117], v[116:117], v[24:25] op_sel_hi:[1,0]
    v_pk_mul_f32 v[118:119], v[118:119], v[24:25] op_sel_hi:[1,0]
    v_pk_mul_f32 v[120:121], v[120:121], v[24:25] op_sel_hi:[1,0]
    v_pk_mul_f32 v[122:123], v[122:123], v[24:25] op_sel_hi:[1,0]
    v_pk_mul_f32 v[124:125], v[124:125], v[24:25] op_sel_hi:[1,0]
    v_pk_mul_f32 v[126:127], v[126:127], v[24:25] op_sel_hi:[1,0]
    v_pk_mul_f32 v[128:129], v[128:129], v[24:25] op_sel_hi:[1,0]
    v_pk_mul_f32 v[130:131], v[130:131], v[24:25] op_sel_hi:[1,0]
    v_pk_mul_f32 v[132:133], v[132:133], v[24:25] op_sel_hi:[1,0]
    v_pk_mul_f32 v[134:135], v[134:135], v[24:25] op_sel_hi:[1,0]
    v_pk_mul_f32 v[136:137], v[136:137], v[24:25] op_sel_hi:[1,0]
    v_pk_mul_f32 v[138:139], v[138:139], v[24:25] op_sel_hi:[1,0]
    v_pk_mul_f32 v[140:141], v[140:141], v[24:25] op_sel_hi:[1,0]
    v_pk_mul_f32 v[142:143], v[142:143], v[24:25] op_sel_hi:[1,0]
    v_pk_mul_f32 v[144:145], v[144:145], v[24:25] op_sel_hi:[1,0]
    v_pk_mul_f32 v[146:147], v[146:147], v[24:25] op_sel_hi:[1,0]
    v_cvt_pk_bf16_f32 v44, v28, v29
    v_cvt_pk_bf16_f32 v45, v30, v31
    v_cvt_pk_bf16_f32 v46, v36, v37
    v_cvt_pk_bf16_f32 v47, v38, v39
    v_cvt_pk_bf16_f32 v48, v32, v33
    v_cvt_pk_bf16_f32 v49, v34, v35
    v_cvt_pk_bf16_f32 v50, v40, v41
    v_cvt_pk_bf16_f32 v51, v42, v43
    v_pk_add_f32 v[28:29], v[28:29], v[30:31]
    v_pk_add_f32 v[36:37], v[36:37], v[38:39]
    v_pk_add_f32 v[32:33], v[32:33], v[34:35]
    v_pk_add_f32 v[40:41], v[40:41], v[42:43]
    v_pk_add_f32 v[28:29], v[28:29], v[36:37]
    v_pk_add_f32 v[32:33], v[32:33], v[40:41]
    v_fma_f32 v10, v10, v22, v28
    v_fma_f32 v11, v11, v24, v32
    v_add_f32 v10, v10, v29
    v_add_f32 v11, v11, v33
    s_nop 1
    v_permlane32_swap_b32 v10, v11
    v_permlane32_swap_b32 v20, v21
    v_add_f32 v10, v10, v11
    v_mov_b32 v11, v10
    s_nop 1
    v_permlane16_swap_b32 v10, v11
    v_add_f32 v21, v10, v11
    ds_write_b64 v189, v[20:21] offset:49152
    s_waitcnt vmcnt(4)
    v_perm_b32 v52, v152, v148, s29
    v_perm_b32 v53, v160, v156, s29
    v_perm_b32 v56, v152, v148, s30
    v_perm_b32 v57, v160, v156, s30
    v_perm_b32 v60, v153, v149, s29
    v_perm_b32 v61, v161, v157, s29
    v_perm_b32 v64, v153, v149, s30
    v_perm_b32 v65, v161, v157, s30
    v_perm_b32 v68, v154, v150, s29
    v_perm_b32 v69, v162, v158, s29
    v_perm_b32 v72, v154, v150, s30
    v_perm_b32 v73, v162, v158, s30
    v_perm_b32 v76, v155, v151, s29
    v_perm_b32 v77, v163, v159, s29
    v_perm_b32 v80, v155, v151, s30
    v_perm_b32 v81, v163, v159, s30
    s_waitcnt vmcnt(0)
    v_perm_b32 v54, v168, v164, s29
    v_perm_b32 v55, v176, v172, s29
    v_perm_b32 v58, v168, v164, s30
    v_perm_b32 v59, v176, v172, s30
    v_mfma_f32_16x16x32_bf16 v[116:119], v[52:55], v[48:51], v[116:119]
    v_perm_b32 v62, v169, v165, s29
    v_perm_b32 v63, v177, v173, s29
    v_mfma_f32_16x16x32_bf16 v[120:123], v[56:59], v[48:51], v[120:123]
    v_perm_b32 v66, v169, v165, s30
    v_perm_b32 v67, v177, v173, s30
    v_mfma_f32_16x16x32_bf16 v[124:127], v[60:63], v[48:51], v[124:127]
    v_perm_b32 v70, v170, v166, s29
    v_perm_b32 v71, v178, v174, s29
    v_mfma_f32_16x16x32_bf16 v[128:131], v[64:67], v[48:51], v[128:131]
    v_perm_b32 v74, v170, v166, s30
    v_perm_b32 v75, v178, v174, s30
    v_mfma_f32_16x16x32_bf16 v[132:135], v[68:71], v[48:51], v[132:135]
    v_perm_b32 v78, v171, v167, s29
    v_perm_b32 v79, v179, v175, s29
    v_mfma_f32_16x16x32_bf16 v[136:139], v[72:75], v[48:51], v[136:139]
    v_perm_b32 v82, v171, v167, s30
    v_perm_b32 v83, v179, v175, s30
    v_mfma_f32_16x16x32_bf16 v[140:143], v[76:79], v[48:51], v[140:143]
    s_nop 0
    v_mfma_f32_16x16x32_bf16 v[144:147], v[80:83], v[48:51], v[144:147]
    v_mfma_f32_16x16x32_bf16 v[84:87], v[52:55], v[44:47], v[84:87]
    ds_write2_b64 v182, v[116:117], v[120:121] offset0:0 offset1:1
    v_mfma_f32_16x16x32_bf16 v[88:91], v[56:59], v[44:47], v[88:91]
    ds_write2_b64 v184, v[118:119], v[122:123] offset0:0 offset1:1
    v_mfma_f32_16x16x32_bf16 v[92:95], v[60:63], v[44:47], v[92:95]
    ds_write2_b64 v182, v[124:125], v[128:129] offset0:128 offset1:129
    v_mfma_f32_16x16x32_bf16 v[96:99], v[64:67], v[44:47], v[96:99]
    ds_write2_b64 v184, v[126:127], v[130:131] offset0:128 offset1:129
    v_mfma_f32_16x16x32_bf16 v[100:103], v[68:71], v[44:47], v[100:103]
    ds_write2_b64 v183, v[132:133], v[136:137] offset0:0 offset1:1
    v_mfma_f32_16x16x32_bf16 v[104:107], v[72:75], v[44:47], v[104:107]
    ds_write2_b64 v185, v[134:135], v[138:139] offset0:0 offset1:1
    ds_write2_b64 v180, v[86:87], v[90:91] offset0:0 offset1:1
    v_mfma_f32_16x16x32_bf16 v[108:111], v[76:79], v[44:47], v[108:111]
    ds_write2_b64 v183, v[140:141], v[144:145] offset0:128 offset1:129
    v_mfma_f32_16x16x32_bf16 v[112:115], v[80:83], v[44:47], v[112:115]
    ds_write2_b64 v185, v[142:143], v[146:147] offset0:128 offset1:129
    ds_write2_b64 v180, v[94:95], v[98:99] offset0:128 offset1:129
    s_nop 0
    ds_write2_b64 v181, v[102:103], v[106:107] offset0:0 offset1:1
    s_nop 3
    ds_write2_b64 v181, v[110:111], v[114:115] offset0:128 offset1:129
    s_waitcnt lgkmcnt(0)
    s_barrier
    ds_read_b64 v[32:33], v190 offset:49152
    ds_read_b64 v[34:35], v191 offset:49152
    ds_read_b64 v[36:37], v192 offset:49152
    ds_read_b64 v[38:39], v193 offset:49152
    ds_read_b128 v[148:151], v186 offset:0
    ds_read_b128 v[164:167], v187 offset:16384
    ds_read_b128 v[52:55], v188 offset:32768
    ds_read_b128 v[152:155], v186 offset:1024
    ds_read_b128 v[168:171], v187 offset:17408
    ds_read_b128 v[56:59], v188 offset:33792
    ds_read_b128 v[156:159], v186 offset:2048
    ds_read_b128 v[172:175], v187 offset:18432
    ds_read_b128 v[60:63], v188 offset:34816
    s_waitcnt lgkmcnt(9)
    v_max3_f32 v40, v32, v34, v36
    v_max_f32 v40, v40, v38
    ds_read_b128 v[160:163], v186 offset:3072
    ds_read_b128 v[176:179], v187 offset:19456
    ds_read_b128 v[64:67], v188 offset:35840
    v_sub_f32 v32, v32, v40
    v_sub_f32 v34, v34, v40
    v_sub_f32 v36, v36, v40
    v_sub_f32 v38, v38, v40
    v_exp_f32 v32, v32
    v_exp_f32 v34, v34
    v_exp_f32 v36, v36
    v_exp_f32 v38, v38
    v_mul_f32 v40, v32, v33
    v_fma_f32 v40, v34, v35, v40
    v_fma_f32 v40, v36, v37, v40
    v_fma_f32 v40, v38, v39, v40
    v_rcp_f32 v40, v40
    s_nop 0
    v_mul_f32 v32, v32, v40
    v_mul_f32 v34, v34, v40
    v_mul_f32 v36, v36, v40
    v_mul_f32 v38, v38, v40
    v_pk_mul_f32 v[84:85], v[84:85], v[32:33] op_sel_hi:[1,0]
    v_pk_mul_f32 v[88:89], v[88:89], v[32:33] op_sel_hi:[1,0]
    v_pk_mul_f32 v[92:93], v[92:93], v[32:33] op_sel_hi:[1,0]
    v_pk_mul_f32 v[96:97], v[96:97], v[32:33] op_sel_hi:[1,0]
    v_pk_mul_f32 v[100:101], v[100:101], v[32:33] op_sel_hi:[1,0]
    v_pk_mul_f32 v[104:105], v[104:105], v[32:33] op_sel_hi:[1,0]
    v_pk_mul_f32 v[108:109], v[108:109], v[32:33] op_sel_hi:[1,0]
    v_pk_mul_f32 v[112:113], v[112:113], v[32:33] op_sel_hi:[1,0]
    s_waitcnt lgkmcnt(11)
    v_pk_fma_f32 v[84:85], v[148:149], v[34:35], v[84:85] op_sel_hi:[1,0,1]
    v_pk_fma_f32 v[88:89], v[150:151], v[34:35], v[88:89] op_sel_hi:[1,0,1]
    s_waitcnt lgkmcnt(10)
    v_pk_fma_f32 v[84:85], v[164:165], v[36:37], v[84:85] op_sel_hi:[1,0,1]
    v_pk_fma_f32 v[88:89], v[166:167], v[36:37], v[88:89] op_sel_hi:[1,0,1]
    s_waitcnt lgkmcnt(9)
    v_pk_fma_f32 v[84:85], v[52:53], v[38:39], v[84:85] op_sel_hi:[1,0,1]
    v_pk_fma_f32 v[88:89], v[54:55], v[38:39], v[88:89] op_sel_hi:[1,0,1]
    v_cvt_pk_bf16_f32 v44, v84, v88
    v_cvt_pk_bf16_f32 v48, v85, v89
    s_waitcnt lgkmcnt(8)
    v_pk_fma_f32 v[92:93], v[152:153], v[34:35], v[92:93] op_sel_hi:[1,0,1]
    v_pk_fma_f32 v[96:97], v[154:155], v[34:35], v[96:97] op_sel_hi:[1,0,1]
    s_waitcnt lgkmcnt(7)
    v_pk_fma_f32 v[92:93], v[168:169], v[36:37], v[92:93] op_sel_hi:[1,0,1]
    v_pk_fma_f32 v[96:97], v[170:171], v[36:37], v[96:97] op_sel_hi:[1,0,1]
    s_waitcnt lgkmcnt(6)
    v_pk_fma_f32 v[92:93], v[56:57], v[38:39], v[92:93] op_sel_hi:[1,0,1]
    v_pk_fma_f32 v[96:97], v[58:59], v[38:39], v[96:97] op_sel_hi:[1,0,1]
    v_cvt_pk_bf16_f32 v45, v92, v96
    v_cvt_pk_bf16_f32 v49, v93, v97
    s_waitcnt lgkmcnt(5)
    v_pk_fma_f32 v[100:101], v[156:157], v[34:35], v[100:101] op_sel_hi:[1,0,1]
    v_pk_fma_f32 v[104:105], v[158:159], v[34:35], v[104:105] op_sel_hi:[1,0,1]
    s_waitcnt lgkmcnt(4)
    v_pk_fma_f32 v[100:101], v[172:173], v[36:37], v[100:101] op_sel_hi:[1,0,1]
    v_pk_fma_f32 v[104:105], v[174:175], v[36:37], v[104:105] op_sel_hi:[1,0,1]
    s_waitcnt lgkmcnt(3)
    v_pk_fma_f32 v[100:101], v[60:61], v[38:39], v[100:101] op_sel_hi:[1,0,1]
    v_pk_fma_f32 v[104:105], v[62:63], v[38:39], v[104:105] op_sel_hi:[1,0,1]
    v_cvt_pk_bf16_f32 v46, v100, v104
    v_cvt_pk_bf16_f32 v50, v101, v105
    s_waitcnt lgkmcnt(2)
    v_pk_fma_f32 v[108:109], v[160:161], v[34:35], v[108:109] op_sel_hi:[1,0,1]
    v_pk_fma_f32 v[112:113], v[162:163], v[34:35], v[112:113] op_sel_hi:[1,0,1]
    s_waitcnt lgkmcnt(1)
    v_pk_fma_f32 v[108:109], v[176:177], v[36:37], v[108:109] op_sel_hi:[1,0,1]
    v_pk_fma_f32 v[112:113], v[178:179], v[36:37], v[112:113] op_sel_hi:[1,0,1]
    s_waitcnt lgkmcnt(0)
    v_pk_fma_f32 v[108:109], v[64:65], v[38:39], v[108:109] op_sel_hi:[1,0,1]
    v_pk_fma_f32 v[112:113], v[66:67], v[38:39], v[112:113] op_sel_hi:[1,0,1]
    v_cvt_pk_bf16_f32 v47, v108, v112
    v_cvt_pk_bf16_f32 v51, v109, v113
    buffer_store_dwordx4 v[44:47], v27, s[24:27], 0 offen offset:0
    buffer_store_dwordx4 v[48:51], v27, s[24:27], 0 offen offset:16
L_end:
    s_endpgm
.section .rodata,"a"
.p2align 6
.amdhsa_kernel standalone__gqa_softmax__sampling_kernel
  .amdhsa_next_free_vgpr 268
  .amdhsa_next_free_sgpr 40
  .amdhsa_accum_offset 204
  .amdhsa_group_segment_fixed_size 0
  .amdhsa_kernarg_size 48
  .amdhsa_user_sgpr_count 2
  .amdhsa_user_sgpr_kernarg_segment_ptr 1
  .amdhsa_system_sgpr_workgroup_id_x 1
  .amdhsa_float_denorm_mode_32 3
.end_amdhsa_kernel
```
